```python
import torch

def _softmax(x, axis=-1):
    return torch.softmax(x, dim=axis)

def _gelu(x):
    return torch.nn.functional.gelu(x, approximate='tanh')

def _silu(x):
    return torch.nn.functional.silu(x)

def _sigmoid(x):
    return torch.sigmoid(x)

def _layernorm(x, axis=-1, eps=1e-05):
    m = x.mean(dim=axis, keepdim=True)
    v = x.var(dim=axis, keepdim=True, unbiased=False)
    return (x - m) / torch.sqrt(v + eps)

def _scatter_add(tgt, idx, src, axis=0):
    return tgt.clone().index_add_(axis, idx, src)

def _segment_sum(src, seg, n):
    out = torch.zeros((n,) + src.shape[1:], dtype=src.dtype)
    return out.index_add_(0, seg, src)

def _pad(x, pw):
    flat = tuple((v for pair in reversed(pw) for v in pair))
    return torch.nn.functional.pad(x, flat)
kernel_name = 'standalone__tree_speculative_verify_tree_attention_over_candidate_token_tree__sampling'

def setup_inputs():

    _w = lambda a: (lambda t: t.to(torch.bfloat16) if t.is_floating_point() else t)(torch.as_tensor(a))
    B, Hq, Hkv, T, C, D = (32, 32, 8, 8, 2048, 128)
    tree_mask = torch.zeros((B, T, T), dtype=float)
    for b in range(B):
        parent = torch.zeros(T, dtype=torch.int64)
        for i in range(1, T):
            parent[i] = int(torch.randint(0, i, (1,)).item())
        for i in range(T):
            j = i
            tree_mask[b, i, j] = 1.0
            while j > 0:
                j = parent[j]
                tree_mask[b, i, j] = 1.0
    return {'q': _w((lambda *s: torch.randn(*s, dtype=torch.bfloat16) * 0.8)(B, Hq, T, D)), 'k_cache': _w((lambda *s: torch.randn(*s, dtype=torch.bfloat16) * 0.8)(B, Hkv, C, D)), 'v_cache': _w((lambda *s: torch.randn(*s, dtype=torch.bfloat16) * 0.05)(B, Hkv, C, D)), 'k_tree': _w((lambda *s: torch.randn(*s, dtype=torch.bfloat16) * 0.8)(B, Hkv, T, D)), 'v_tree': _w((lambda *s: torch.randn(*s, dtype=torch.bfloat16) * 0.05)(B, Hkv, T, D)), 'tree_mask': _w(tree_mask)}

def reference(q, k_cache, v_cache, k_tree, v_tree, tree_mask):
    B, Hq, T, D = q.shape
    Hkv, C = (k_cache.shape[1], k_cache.shape[2])
    rep = Hq // Hkv
    kc = (lambda x, n, axis: torch.repeat_interleave(x, n, dim=axis))(k_cache, rep, axis=1)
    vc = (lambda x, n, axis: torch.repeat_interleave(x, n, dim=axis))(v_cache, rep, axis=1)
    kt = (lambda x, n, axis: torch.repeat_interleave(x, n, dim=axis))(k_tree, rep, axis=1)
    vt = (lambda x, n, axis: torch.repeat_interleave(x, n, dim=axis))(v_tree, rep, axis=1)
    k = torch.concatenate([kc, kt], axis=2)
    v = torch.concatenate([vc, vt], axis=2)
    scale = D ** (-0.5)
    scores = torch.einsum('bhqd,bhkd->bhqk', q, k) * scale
    ctx_mask = torch.ones((B, 1, T, C), dtype=scores.dtype)
    tm = tree_mask[:, None, :, :].clone()
    full_mask = torch.concatenate([ctx_mask, tm], axis=-1)
    scores = scores + (1.0 - full_mask) * -1000000000.0
    p = _softmax(scores, axis=-1)
    return torch.einsum('bhqk,bhkd->bhqd', p, v)
```

```asm
; @launch grid=(256,1,1) block=(512,1,1) lds=147456
.amdgcn_target "amdgcn-amd-amdhsa--gfx950"
.text
.globl standalone__tree_speculative_verify_tree_attention_over_candidate_token_tree__sampling_kernel
.p2align 8
.type standalone__tree_speculative_verify_tree_attention_over_candidate_token_tree__sampling_kernel,@function
standalone__tree_speculative_verify_tree_attention_over_candidate_token_tree__sampling_kernel:
    s_cmp_ge_u32 s2, 256
    s_cbranch_scc1 L_end
    s_load_dwordx8 s[4:11], s[0:1], 0
    s_mov_b32 s85, s2
    s_bfe_u32 s3, s2, 0x20003
    s_xor_b32 s2, s2, s3
    s_load_dwordx4 s[12:15], s[0:1], 32
    s_load_dwordx2 s[16:17], s[0:1], 48
    v_lshrrev_b32 v18, 6, v0
    v_and_b32 v0, 63, v0
    v_readfirstlane_b32 s48, v18
    v_and_b32 v19, 15, v0
    v_lshrrev_b32 v20, 4, v0
    v_xor_b32 v21, v19, v20
    v_lshlrev_b32 v21, 4, v21
    v_lshlrev_b32 v22, 2, v20
    v_xor_b32 v22, v19, v22
    v_lshlrev_b32 v22, 4, v22
    v_lshl_add_u32 v1, v20, 8, v22
    v_xor_b32 v2, 16, v1
    v_xor_b32 v3, 32, v1
    v_xor_b32 v4, 48, v1
    s_lshl_b32 s49, s48, 14
    v_and_b32 v22, 3, v19
    v_lshrrev_b32 v23, 2, v19
    v_lshl_add_u32 v22, v22, 2, v23
    v_lshl_add_u32 v22, v22, 8, v21
    v_add_u32 v5, s49, v22
    v_xor_b32 v6, 64, v5
    v_xor_b32 v7, 128, v5
    v_xor_b32 v8, 192, v5
    v_lshlrev_b32 v22, 4, v19
    v_lshl_add_u32 v9, v20, 8, v22
    v_lshlrev_b32 v22, 4, v20
    v_lshl_add_u32 v23, v19, 8, v22
    s_lshl_b32 s52, s2, 19
    s_lshr_b32 s60, s48, 2
    s_mul_i32 s60, s60, 16384
    s_add_u32 s52, s52, s60
    s_and_b32 s60, s48, 3
    s_mul_i32 s60, s60, 1024
    v_add_u32 v2, 0xc00, v2
    v_add_u32 v252, 0x1000, v9
    v_add_u32 v3, 0x1800, v3
    v_add_u32 v253, 0x2000, v9
    v_add_u32 v4, 0x2400, v4
    v_add_u32 v254, 0x3000, v9
    s_add_u32 s52, s52, s60
    s_add_u32 s53, s52, 65536
    s_add_u32 s54, s52, 32768
    s_add_u32 s55, s52, 98304
    s_lshl_b32 s60, s2, 13
    s_add_u32 s61, s60, 4096
    s_mov_b32 s56, 0x3e0293ee
    s_mov_b32 s57, 0x05040100
    s_mov_b32 s58, 0x07060302
    s_mov_b32 s59, 0x5028965f
    s_mov_b32 s63, 0x80000000
    s_waitcnt lgkmcnt(0)
    s_mov_b32 s20, s6
    s_and_b32 s21, s7, 0xffff
    s_mov_b32 s22, 0x8000000
    s_mov_b32 s23, 0x00020000
    s_cmp_lt_u32 s48, 4
    s_cbranch_scc1 L_nohold
    s_barrier
L_nohold:
    s_add_u32 m0, s49, 0
    s_nop 0
    buffer_load_dwordx4 v1, s[20:23], s52 offen offset:0 nt lds
    buffer_load_dwordx4 v2, s[20:23], s52 offen offset:1024 nt lds
    buffer_load_dwordx4 v3, s[20:23], s52 offen offset:2048 nt lds
    buffer_load_dwordx4 v4, s[20:23], s52 offen offset:3072 nt lds
    s_add_u32 m0, s49, 4096
    s_nop 0
    buffer_load_dwordx4 v1, s[20:23], s53 offen offset:0 nt lds
    buffer_load_dwordx4 v2, s[20:23], s53 offen offset:1024 nt lds
    buffer_load_dwordx4 v3, s[20:23], s53 offen offset:2048 nt lds
    buffer_load_dwordx4 v4, s[20:23], s53 offen offset:3072 nt lds
    s_mov_b32 s28, s4
    s_and_b32 s29, s5, 0xffff
    s_mov_b32 s30, 0x200000
    s_mov_b32 s31, 0x00020000
    s_mov_b32 s24, s8
    s_and_b32 s25, s9, 0xffff
    s_mov_b32 s26, 0x8000000
    s_mov_b32 s27, 0x00020000
    buffer_load_dwordx4 v[24:27], v23, s[28:31], s60 offen offset:0
    buffer_load_dwordx4 v[28:31], v23, s[28:31], s60 offen offset:64
    buffer_load_dwordx4 v[32:35], v23, s[28:31], s60 offen offset:128
    buffer_load_dwordx4 v[36:39], v23, s[28:31], s60 offen offset:192
    buffer_load_dwordx4 v[40:43], v23, s[28:31], s61 offen offset:0
    buffer_load_dwordx4 v[44:47], v23, s[28:31], s61 offen offset:64
    buffer_load_dwordx4 v[48:51], v23, s[28:31], s61 offen offset:128
    buffer_load_dwordx4 v[52:55], v23, s[28:31], s61 offen offset:192
    s_add_u32 m0, s49, 8192
    s_nop 0
    buffer_load_dwordx4 v1, s[20:23], s54 offen offset:0 nt lds
    buffer_load_dwordx4 v2, s[20:23], s54 offen offset:1024 nt lds
    buffer_load_dwordx4 v3, s[20:23], s54 offen offset:2048 nt lds
    buffer_load_dwordx4 v4, s[20:23], s54 offen offset:3072 nt lds
    s_add_u32 m0, s49, 12288
    s_nop 0
    buffer_load_dwordx4 v1, s[20:23], s55 offen offset:0 nt lds
    buffer_load_dwordx4 v2, s[20:23], s55 offen offset:1024 nt lds
    buffer_load_dwordx4 v3, s[20:23], s55 offen offset:2048 nt lds
    buffer_load_dwordx4 v4, s[20:23], s55 offen offset:3072 nt lds
    buffer_load_dwordx4 v[120:123], v9, s[24:27], s52 offen offset:0 nt
    buffer_load_dwordx4 v[124:127], v252, s[24:27], s52 offen offset:0 nt
    buffer_load_dwordx4 v[128:131], v253, s[24:27], s52 offen offset:0 nt
    buffer_load_dwordx4 v[132:135], v254, s[24:27], s52 offen offset:0 nt
    buffer_load_dwordx4 v[136:139], v9, s[24:27], s53 offen offset:0 nt
    buffer_load_dwordx4 v[140:143], v252, s[24:27], s53 offen offset:0 nt
    buffer_load_dwordx4 v[144:147], v253, s[24:27], s53 offen offset:0 nt
    buffer_load_dwordx4 v[148:151], v254, s[24:27], s53 offen offset:0 nt
    s_mov_b32 s32, s10
    s_and_b32 s33, s11, 0xffff
    s_mov_b32 s34, 0x80000
    s_mov_b32 s35, 0x00020000
    s_mov_b32 s36, s12
    s_and_b32 s37, s13, 0xffff
    s_mov_b32 s38, 0x80000
    s_mov_b32 s39, 0x00020000
    s_mov_b32 s40, s14
    s_and_b32 s41, s15, 0xffff
    s_mov_b32 s42, 0x1000
    s_mov_b32 s43, 0x00020000
    s_mov_b32 s44, s16
    s_and_b32 s45, s17, 0xffff
    s_mov_b32 s46, 0x200000
    s_mov_b32 s47, 0x00020000
    s_mov_b32 s50, 0
    s_cmp_lt_u32 s48, 4
    s_cselect_b32 s51, 3, 99
    s_cselect_b32 s62, 1, 99
    s_cmp_lt_u32 s48, 4
    s_cselect_b32 s94, 99, 3
    s_cselect_b32 s87, 99, 2
    s_mov_b32 s86, s85
    v_mov_b32 v56, 0
    v_mov_b32 v57, 0
    v_mov_b32 v58, 0
    v_mov_b32 v59, 0
    v_mov_b32 v60, 0
    v_mov_b32 v61, 0
    v_mov_b32 v62, 0
    v_mov_b32 v63, 0
    v_mov_b32 v64, 0
    v_mov_b32 v65, 0
    v_mov_b32 v66, 0
    v_mov_b32 v67, 0
    v_mov_b32 v68, 0
    v_mov_b32 v69, 0
    v_mov_b32 v70, 0
    v_mov_b32 v71, 0
    v_mov_b32 v72, 0
    v_mov_b32 v73, 0
    v_mov_b32 v74, 0
    v_mov_b32 v75, 0
    v_mov_b32 v76, 0
    v_mov_b32 v77, 0
    v_mov_b32 v78, 0
    v_mov_b32 v79, 0
    v_mov_b32 v80, 0
    v_mov_b32 v81, 0
    v_mov_b32 v82, 0
    v_mov_b32 v83, 0
    v_mov_b32 v84, 0
    v_mov_b32 v85, 0
    v_mov_b32 v86, 0
    v_mov_b32 v87, 0
    v_mov_b32 v88, 0
    v_mov_b32 v89, 0
    v_mov_b32 v90, 0
    v_mov_b32 v91, 0
    v_mov_b32 v92, 0
    v_mov_b32 v93, 0
    v_mov_b32 v94, 0
    v_mov_b32 v95, 0
    v_mov_b32 v96, 0
    v_mov_b32 v97, 0
    v_mov_b32 v98, 0
    v_mov_b32 v99, 0
    v_mov_b32 v100, 0
    v_mov_b32 v101, 0
    v_mov_b32 v102, 0
    v_mov_b32 v103, 0
    v_mov_b32 v104, 0
    v_mov_b32 v105, 0
    v_mov_b32 v106, 0
    v_mov_b32 v107, 0
    v_mov_b32 v108, 0
    v_mov_b32 v109, 0
    v_mov_b32 v110, 0
    v_mov_b32 v111, 0
    v_mov_b32 v112, 0
    v_mov_b32 v113, 0
    v_mov_b32 v114, 0
    v_mov_b32 v115, 0
    v_mov_b32 v116, 0
    v_mov_b32 v117, 0
    v_mov_b32 v118, 0
    v_mov_b32 v119, 0
    v_mov_b32 v10, 0xff800000
    v_mov_b32 v12, 0
    v_mov_b32 v11, 0xff800000
    v_mov_b32 v13, 0
L_loop:
    s_cmp_eq_u32 s50, s51
    s_cbranch_scc1 L_tree
L_loop2:
    s_cmp_eq_u32 s50, s62
    s_cbranch_scc1 L_treeld
L_loop3:
    s_cmp_eq_u32 s50, s94
    s_cbranch_scc1 L_merge
L_loop4:
    s_cmp_eq_u32 s50, s87
    s_cselect_b32 s86, 1, s86
    s_mov_b32 s88, s52
    s_mov_b32 s89, s53
    s_mov_b32 s90, s54
    s_mov_b32 s91, s55
    s_add_u32 s60, s88, 131072
    s_cmp_lt_u32 s50, 3
    s_cselect_b32 s52, s60, s63
    s_add_u32 s53, s52, 65536
    s_add_u32 s54, s52, 32768
    s_add_u32 s55, s52, 98304
    s_waitcnt vmcnt(16)
    ds_read_b128 v[216:219], v5 offset:0
    ds_read_b128 v[220:223], v6 offset:0
    ds_read_b128 v[224:227], v7 offset:0
    ds_read_b128 v[228:231], v8 offset:0
    ds_read_b128 v[232:235], v5 offset:4096
    ds_read_b128 v[236:239], v6 offset:4096
    ds_read_b128 v[240:243], v7 offset:4096
    ds_read_b128 v[244:247], v8 offset:4096
    s_waitcnt lgkmcnt(7)
    v_mfma_f32_16x16x32_bf16 v[184:187], v[216:219], v[24:27], 0
    v_mfma_f32_16x16x32_bf16 v[188:191], v[216:219], v[40:43], 0
    s_waitcnt lgkmcnt(6)
    v_mfma_f32_16x16x32_bf16 v[184:187], v[220:223], v[28:31], v[184:187]
    v_mfma_f32_16x16x32_bf16 v[188:191], v[220:223], v[44:47], v[188:191]
    s_waitcnt lgkmcnt(5)
    v_mfma_f32_16x16x32_bf16 v[184:187], v[224:227], v[32:35], v[184:187]
    v_mfma_f32_16x16x32_bf16 v[188:191], v[224:227], v[48:51], v[188:191]
    s_waitcnt lgkmcnt(4)
    v_mfma_f32_16x16x32_bf16 v[184:187], v[228:231], v[36:39], v[184:187]
    v_mfma_f32_16x16x32_bf16 v[188:191], v[228:231], v[52:55], v[188:191]
    s_waitcnt lgkmcnt(3)
    v_mfma_f32_16x16x32_bf16 v[192:195], v[232:235], v[24:27], 0
    v_mfma_f32_16x16x32_bf16 v[196:199], v[232:235], v[40:43], 0
    s_waitcnt lgkmcnt(2)
    v_mfma_f32_16x16x32_bf16 v[192:195], v[236:239], v[28:31], v[192:195]
    v_mfma_f32_16x16x32_bf16 v[196:199], v[236:239], v[44:47], v[196:199]
    s_waitcnt lgkmcnt(1)
    v_mfma_f32_16x16x32_bf16 v[192:195], v[240:243], v[32:35], v[192:195]
    v_mfma_f32_16x16x32_bf16 v[196:199], v[240:243], v[48:51], v[196:199]
    s_waitcnt lgkmcnt(0)
    v_mfma_f32_16x16x32_bf16 v[192:195], v[244:247], v[36:39], v[192:195]
    v_mfma_f32_16x16x32_bf16 v[196:199], v[244:247], v[52:55], v[196:199]
    s_cmp_lg_u32 s50, s51
    s_cbranch_scc1 L_nhp
    s_barrier
L_nhp:
    s_bitcmp1_b32 s86, 0
    s_cbranch_scc1 L_nt1
    s_waitcnt vmcnt(1)
L_nt1:
    buffer_load_dwordx4 v[152:155], v9, s[24:27], s90 offen offset:0 nt
    buffer_load_dwordx4 v[156:159], v252, s[24:27], s90 offen offset:0 nt
    buffer_load_dwordx4 v[160:163], v253, s[24:27], s90 offen offset:0 nt
    buffer_load_dwordx4 v[164:167], v254, s[24:27], s90 offen offset:0 nt
    buffer_load_dwordx4 v[168:171], v9, s[24:27], s91 offen offset:0 nt
    buffer_load_dwordx4 v[172:175], v252, s[24:27], s91 offen offset:0 nt
    buffer_load_dwordx4 v[176:179], v253, s[24:27], s91 offen offset:0 nt
    buffer_load_dwordx4 v[180:183], v254, s[24:27], s91 offen offset:0 nt
    s_waitcnt vmcnt(16)
    ds_read_b128 v[216:219], v5 offset:8192
    ds_read_b128 v[220:223], v6 offset:8192
    ds_read_b128 v[224:227], v7 offset:8192
    ds_read_b128 v[228:231], v8 offset:8192
    ds_read_b128 v[232:235], v5 offset:12288
    ds_read_b128 v[236:239], v6 offset:12288
    ds_read_b128 v[240:243], v7 offset:12288
    ds_read_b128 v[244:247], v8 offset:12288
    s_waitcnt lgkmcnt(7)
    v_mfma_f32_16x16x32_bf16 v[200:203], v[216:219], v[24:27], 0
    v_mfma_f32_16x16x32_bf16 v[204:207], v[216:219], v[40:43], 0
    s_waitcnt lgkmcnt(6)
    v_mfma_f32_16x16x32_bf16 v[200:203], v[220:223], v[28:31], v[200:203]
    v_mfma_f32_16x16x32_bf16 v[204:207], v[220:223], v[44:47], v[204:207]
    s_waitcnt lgkmcnt(5)
    v_mfma_f32_16x16x32_bf16 v[200:203], v[224:227], v[32:35], v[200:203]
    v_mfma_f32_16x16x32_bf16 v[204:207], v[224:227], v[48:51], v[204:207]
    s_waitcnt lgkmcnt(4)
    v_mfma_f32_16x16x32_bf16 v[200:203], v[228:231], v[36:39], v[200:203]
    v_mfma_f32_16x16x32_bf16 v[204:207], v[228:231], v[52:55], v[204:207]
    s_waitcnt lgkmcnt(3)
    v_mfma_f32_16x16x32_bf16 v[208:211], v[232:235], v[24:27], 0
    v_mfma_f32_16x16x32_bf16 v[212:215], v[232:235], v[40:43], 0
    s_waitcnt lgkmcnt(2)
    v_mfma_f32_16x16x32_bf16 v[208:211], v[236:239], v[28:31], v[208:211]
    v_mfma_f32_16x16x32_bf16 v[212:215], v[236:239], v[44:47], v[212:215]
    s_waitcnt lgkmcnt(1)
    v_mfma_f32_16x16x32_bf16 v[208:211], v[240:243], v[32:35], v[208:211]
    v_mfma_f32_16x16x32_bf16 v[212:215], v[240:243], v[48:51], v[212:215]
    s_waitcnt lgkmcnt(0)
    v_mfma_f32_16x16x32_bf16 v[208:211], v[244:247], v[36:39], v[208:211]
    v_mfma_f32_16x16x32_bf16 v[212:215], v[244:247], v[52:55], v[212:215]
    s_bitcmp1_b32 s86, 0
    s_cbranch_scc1 L_nt2
    s_waitcnt vmcnt(1)
L_nt2:
    s_cmp_eq_u32 s50, 3
    s_cbranch_scc1 L_skip1
    s_add_u32 m0, s49, 0
    s_nop 0
    buffer_load_dwordx4 v1, s[20:23], s52 offen offset:0 nt lds
    buffer_load_dwordx4 v2, s[20:23], s52 offen offset:1024 nt lds
    buffer_load_dwordx4 v3, s[20:23], s52 offen offset:2048 nt lds
    buffer_load_dwordx4 v4, s[20:23], s52 offen offset:3072 nt lds
    s_add_u32 m0, s49, 4096
    s_nop 0
    buffer_load_dwordx4 v1, s[20:23], s53 offen offset:0 nt lds
    buffer_load_dwordx4 v2, s[20:23], s53 offen offset:1024 nt lds
    buffer_load_dwordx4 v3, s[20:23], s53 offen offset:2048 nt lds
    buffer_load_dwordx4 v4, s[20:23], s53 offen offset:3072 nt lds
L_done1:
    v_max3_f32 v18, v184, v185, v10
    v_max3_f32 v18, v186, v187, v18
    v_max3_f32 v18, v192, v193, v18
    v_max3_f32 v18, v194, v195, v18
    v_max3_f32 v18, v200, v201, v18
    v_max3_f32 v18, v202, v203, v18
    v_max3_f32 v18, v208, v209, v18
    v_max3_f32 v18, v210, v211, v18
    v_max3_f32 v19, v188, v189, v11
    v_max3_f32 v19, v190, v191, v19
    v_max3_f32 v19, v196, v197, v19
    v_max3_f32 v19, v198, v199, v19
    v_max3_f32 v19, v204, v205, v19
    v_max3_f32 v19, v206, v207, v19
    v_max3_f32 v19, v212, v213, v19
    v_max3_f32 v19, v214, v215, v19
    v_mov_b32 v20, v18
    v_mov_b32 v21, v19
    s_nop 1
    v_permlane32_swap_b32 v18, v20
    v_permlane32_swap_b32 v19, v21
    s_nop 0
    v_max_f32 v18, v18, v20
    v_max_f32 v19, v19, v21
    v_mov_b32 v20, v18
    v_mov_b32 v21, v19
    s_nop 1
    v_permlane16_swap_b32 v18, v20
    v_permlane16_swap_b32 v19, v21
    s_nop 0
    v_max_f32 v18, v18, v20
    v_max_f32 v19, v19, v21
    v_sub_f32 v14, v10, v18
    v_mul_f32 v16, s56, v18
    v_mul_f32 v14, s56, v14
    v_mov_b32 v10, v18
    v_sub_f32 v15, v11, v19
    v_mul_f32 v17, s56, v19
    v_mul_f32 v15, s56, v15
    v_mov_b32 v11, v19
    v_exp_f32 v14, v14
    v_exp_f32 v15, v15
    v_fma_f32 v184, v184, s56, -v16
    v_fma_f32 v185, v185, s56, -v16
    v_fma_f32 v186, v186, s56, -v16
    v_fma_f32 v187, v187, s56, -v16
    v_fma_f32 v188, v188, s56, -v17
    v_fma_f32 v189, v189, s56, -v17
    v_fma_f32 v190, v190, s56, -v17
    v_fma_f32 v191, v191, s56, -v17
    v_fma_f32 v192, v192, s56, -v16
    v_fma_f32 v193, v193, s56, -v16
    v_fma_f32 v194, v194, s56, -v16
    v_fma_f32 v195, v195, s56, -v16
    v_fma_f32 v196, v196, s56, -v17
    v_fma_f32 v197, v197, s56, -v17
    v_fma_f32 v198, v198, s56, -v17
    v_fma_f32 v199, v199, s56, -v17
    v_fma_f32 v200, v200, s56, -v16
    v_fma_f32 v201, v201, s56, -v16
    v_fma_f32 v202, v202, s56, -v16
    v_fma_f32 v203, v203, s56, -v16
    v_fma_f32 v204, v204, s56, -v17
    v_fma_f32 v205, v205, s56, -v17
    v_fma_f32 v206, v206, s56, -v17
    v_fma_f32 v207, v207, s56, -v17
    v_fma_f32 v208, v208, s56, -v16
    v_fma_f32 v209, v209, s56, -v16
    v_fma_f32 v210, v210, s56, -v16
    v_fma_f32 v211, v211, s56, -v16
    v_fma_f32 v212, v212, s56, -v17
    v_fma_f32 v213, v213, s56, -v17
    v_fma_f32 v214, v214, s56, -v17
    v_fma_f32 v215, v215, s56, -v17
    v_exp_f32 v184, v184
    v_exp_f32 v185, v185
    v_exp_f32 v186, v186
    v_exp_f32 v187, v187
    v_exp_f32 v188, v188
    v_exp_f32 v189, v189
    v_exp_f32 v190, v190
    v_exp_f32 v191, v191
    v_exp_f32 v192, v192
    v_exp_f32 v193, v193
    v_exp_f32 v194, v194
    v_exp_f32 v195, v195
    v_exp_f32 v196, v196
    v_exp_f32 v197, v197
    v_exp_f32 v198, v198
    v_exp_f32 v199, v199
    v_exp_f32 v200, v200
    v_exp_f32 v201, v201
    v_exp_f32 v202, v202
    v_exp_f32 v203, v203
    v_exp_f32 v204, v204
    v_exp_f32 v205, v205
    v_exp_f32 v206, v206
    v_exp_f32 v207, v207
    v_exp_f32 v208, v208
    v_exp_f32 v209, v209
    v_exp_f32 v210, v210
    v_exp_f32 v211, v211
    v_exp_f32 v212, v212
    v_exp_f32 v213, v213
    v_exp_f32 v214, v214
    v_exp_f32 v215, v215
    v_pk_mul_f32 v[56:57], v[56:57], v[14:15] op_sel:[0,0] op_sel_hi:[1,0]
    v_pk_mul_f32 v[58:59], v[58:59], v[14:15] op_sel:[0,0] op_sel_hi:[1,0]
    v_pk_mul_f32 v[60:61], v[60:61], v[14:15] op_sel:[0,1] op_sel_hi:[1,1]
    v_pk_mul_f32 v[62:63], v[62:63], v[14:15] op_sel:[0,1] op_sel_hi:[1,1]
    v_pk_mul_f32 v[64:65], v[64:65], v[14:15] op_sel:[0,0] op_sel_hi:[1,0]
    v_pk_mul_f32 v[66:67], v[66:67], v[14:15] op_sel:[0,0] op_sel_hi:[1,0]
    v_pk_mul_f32 v[68:69], v[68:69], v[14:15] op_sel:[0,1] op_sel_hi:[1,1]
    v_pk_mul_f32 v[70:71], v[70:71], v[14:15] op_sel:[0,1] op_sel_hi:[1,1]
    v_pk_mul_f32 v[72:73], v[72:73], v[14:15] op_sel:[0,0] op_sel_hi:[1,0]
    v_pk_mul_f32 v[74:75], v[74:75], v[14:15] op_sel:[0,0] op_sel_hi:[1,0]
    v_pk_mul_f32 v[76:77], v[76:77], v[14:15] op_sel:[0,1] op_sel_hi:[1,1]
    v_pk_mul_f32 v[78:79], v[78:79], v[14:15] op_sel:[0,1] op_sel_hi:[1,1]
    v_pk_mul_f32 v[80:81], v[80:81], v[14:15] op_sel:[0,0] op_sel_hi:[1,0]
    v_pk_mul_f32 v[82:83], v[82:83], v[14:15] op_sel:[0,0] op_sel_hi:[1,0]
    v_pk_mul_f32 v[84:85], v[84:85], v[14:15] op_sel:[0,1] op_sel_hi:[1,1]
    v_pk_mul_f32 v[86:87], v[86:87], v[14:15] op_sel:[0,1] op_sel_hi:[1,1]
    v_pk_mul_f32 v[88:89], v[88:89], v[14:15] op_sel:[0,0] op_sel_hi:[1,0]
    v_pk_mul_f32 v[90:91], v[90:91], v[14:15] op_sel:[0,0] op_sel_hi:[1,0]
    v_pk_mul_f32 v[92:93], v[92:93], v[14:15] op_sel:[0,1] op_sel_hi:[1,1]
    v_pk_mul_f32 v[94:95], v[94:95], v[14:15] op_sel:[0,1] op_sel_hi:[1,1]
    v_pk_mul_f32 v[96:97], v[96:97], v[14:15] op_sel:[0,0] op_sel_hi:[1,0]
    v_pk_mul_f32 v[98:99], v[98:99], v[14:15] op_sel:[0,0] op_sel_hi:[1,0]
    v_pk_mul_f32 v[100:101], v[100:101], v[14:15] op_sel:[0,1] op_sel_hi:[1,1]
    v_pk_mul_f32 v[102:103], v[102:103], v[14:15] op_sel:[0,1] op_sel_hi:[1,1]
    v_pk_mul_f32 v[104:105], v[104:105], v[14:15] op_sel:[0,0] op_sel_hi:[1,0]
    v_pk_mul_f32 v[106:107], v[106:107], v[14:15] op_sel:[0,0] op_sel_hi:[1,0]
    v_pk_mul_f32 v[108:109], v[108:109], v[14:15] op_sel:[0,1] op_sel_hi:[1,1]
    v_pk_mul_f32 v[110:111], v[110:111], v[14:15] op_sel:[0,1] op_sel_hi:[1,1]
    v_pk_mul_f32 v[112:113], v[112:113], v[14:15] op_sel:[0,0] op_sel_hi:[1,0]
    v_pk_mul_f32 v[114:115], v[114:115], v[14:15] op_sel:[0,0] op_sel_hi:[1,0]
    v_pk_mul_f32 v[116:117], v[116:117], v[14:15] op_sel:[0,1] op_sel_hi:[1,1]
    v_pk_mul_f32 v[118:119], v[118:119], v[14:15] op_sel:[0,1] op_sel_hi:[1,1]
    v_add_f32 v18, v184, v185
    v_add_f32 v20, v186, v187
    v_add_f32 v18, v18, v192
    v_add_f32 v20, v20, v193
    v_add_f32 v18, v18, v194
    v_add_f32 v20, v20, v195
    v_add_f32 v18, v18, v200
    v_add_f32 v20, v20, v201
    v_add_f32 v18, v18, v202
    v_add_f32 v20, v20, v203
    v_add_f32 v18, v18, v208
    v_add_f32 v20, v20, v209
    v_add_f32 v18, v18, v210
    v_add_f32 v20, v20, v211
    v_add_f32 v18, v18, v20
    v_fma_f32 v12, v12, v14, v18
    v_add_f32 v19, v188, v189
    v_add_f32 v21, v190, v191
    v_add_f32 v19, v19, v196
    v_add_f32 v21, v21, v197
    v_add_f32 v19, v19, v198
    v_add_f32 v21, v21, v199
    v_add_f32 v19, v19, v204
    v_add_f32 v21, v21, v205
    v_add_f32 v19, v19, v206
    v_add_f32 v21, v21, v207
    v_add_f32 v19, v19, v212
    v_add_f32 v21, v21, v213
    v_add_f32 v19, v19, v214
    v_add_f32 v21, v21, v215
    v_add_f32 v19, v19, v21
    v_fma_f32 v13, v13, v15, v19
    v_cvt_pk_bf16_f32 v184, v184, v185
    v_cvt_pk_bf16_f32 v185, v186, v187
    v_cvt_pk_bf16_f32 v186, v192, v193
    v_cvt_pk_bf16_f32 v187, v194, v195
    v_cvt_pk_bf16_f32 v188, v188, v189
    v_cvt_pk_bf16_f32 v189, v190, v191
    v_cvt_pk_bf16_f32 v190, v196, v197
    v_cvt_pk_bf16_f32 v191, v198, v199
    v_cvt_pk_bf16_f32 v200, v200, v201
    v_cvt_pk_bf16_f32 v201, v202, v203
    v_cvt_pk_bf16_f32 v202, v208, v209
    v_cvt_pk_bf16_f32 v203, v210, v211
    v_cvt_pk_bf16_f32 v204, v204, v205
    v_cvt_pk_bf16_f32 v205, v206, v207
    v_cvt_pk_bf16_f32 v206, v212, v213
    v_cvt_pk_bf16_f32 v207, v214, v215
    s_waitcnt vmcnt(16)
    s_cmp_eq_u32 s50, 3
    s_cbranch_scc1 L_w2
L_wd2:
    v_perm_b32 v216, v124, v120, s57
    v_perm_b32 v217, v132, v128, s57
    v_perm_b32 v218, v140, v136, s57
    v_perm_b32 v219, v148, v144, s57
    v_perm_b32 v220, v124, v120, s58
    v_perm_b32 v221, v132, v128, s58
    v_perm_b32 v222, v140, v136, s58
    v_perm_b32 v223, v148, v144, s58
    v_mfma_f32_16x16x32_bf16 v[56:59], v[216:219], v[184:187], v[56:59]
    v_mfma_f32_16x16x32_bf16 v[60:63], v[216:219], v[188:191], v[60:63]
    v_perm_b32 v224, v125, v121, s57
    v_perm_b32 v225, v133, v129, s57
    v_perm_b32 v226, v141, v137, s57
    v_perm_b32 v227, v149, v145, s57
    v_mfma_f32_16x16x32_bf16 v[64:67], v[220:223], v[184:187], v[64:67]
    v_mfma_f32_16x16x32_bf16 v[68:71], v[220:223], v[188:191], v[68:71]
    v_perm_b32 v228, v125, v121, s58
    v_perm_b32 v229, v133, v129, s58
    v_perm_b32 v230, v141, v137, s58
    v_perm_b32 v231, v149, v145, s58
    v_mfma_f32_16x16x32_bf16 v[72:75], v[224:227], v[184:187], v[72:75]
    v_mfma_f32_16x16x32_bf16 v[76:79], v[224:227], v[188:191], v[76:79]
    v_perm_b32 v232, v126, v122, s57
    v_perm_b32 v233, v134, v130, s57
    v_perm_b32 v234, v142, v138, s57
    v_perm_b32 v235, v150, v146, s57
    v_mfma_f32_16x16x32_bf16 v[80:83], v[228:231], v[184:187], v[80:83]
    v_mfma_f32_16x16x32_bf16 v[84:87], v[228:231], v[188:191], v[84:87]
    v_perm_b32 v236, v126, v122, s58
    v_perm_b32 v237, v134, v130, s58
    v_perm_b32 v238, v142, v138, s58
    v_perm_b32 v239, v150, v146, s58
    v_mfma_f32_16x16x32_bf16 v[88:91], v[232:235], v[184:187], v[88:91]
    v_mfma_f32_16x16x32_bf16 v[92:95], v[232:235], v[188:191], v[92:95]
    v_perm_b32 v240, v127, v123, s57
    v_perm_b32 v241, v135, v131, s57
    v_perm_b32 v242, v143, v139, s57
    v_perm_b32 v243, v151, v147, s57
    v_mfma_f32_16x16x32_bf16 v[96:99], v[236:239], v[184:187], v[96:99]
    v_mfma_f32_16x16x32_bf16 v[100:103], v[236:239], v[188:191], v[100:103]
    v_perm_b32 v244, v127, v123, s58
    v_perm_b32 v245, v135, v131, s58
    v_perm_b32 v246, v143, v139, s58
    v_perm_b32 v247, v151, v147, s58
    v_mfma_f32_16x16x32_bf16 v[104:107], v[240:243], v[184:187], v[104:107]
    v_mfma_f32_16x16x32_bf16 v[108:111], v[240:243], v[188:191], v[108:111]
    s_bitcmp1_b32 s86, 0
    s_cbranch_scc1 L_nt3
    s_waitcnt vmcnt(1)
L_nt3:
    s_cmp_eq_u32 s50, 3
    s_cbranch_scc1 L_skip2
    s_add_u32 m0, s49, 8192
    s_nop 0
    buffer_load_dwordx4 v1, s[20:23], s54 offen offset:0 nt lds
    buffer_load_dwordx4 v2, s[20:23], s54 offen offset:1024 nt lds
    buffer_load_dwordx4 v3, s[20:23], s54 offen offset:2048 nt lds
    buffer_load_dwordx4 v4, s[20:23], s54 offen offset:3072 nt lds
    s_add_u32 m0, s49, 12288
    s_nop 0
    buffer_load_dwordx4 v1, s[20:23], s55 offen offset:0 nt lds
    buffer_load_dwordx4 v2, s[20:23], s55 offen offset:1024 nt lds
    buffer_load_dwordx4 v3, s[20:23], s55 offen offset:2048 nt lds
    buffer_load_dwordx4 v4, s[20:23], s55 offen offset:3072 nt lds
L_done2:
    v_mfma_f32_16x16x32_bf16 v[112:115], v[244:247], v[184:187], v[112:115]
    v_mfma_f32_16x16x32_bf16 v[116:119], v[244:247], v[188:191], v[116:119]
    s_waitcnt vmcnt(16)
    s_cmp_eq_u32 s50, 3
    s_cbranch_scc1 L_w3
L_wd3:
    v_perm_b32 v216, v156, v152, s57
    v_perm_b32 v217, v164, v160, s57
    v_perm_b32 v218, v172, v168, s57
    v_perm_b32 v219, v180, v176, s57
    v_perm_b32 v220, v156, v152, s58
    v_perm_b32 v221, v164, v160, s58
    v_perm_b32 v222, v172, v168, s58
    v_perm_b32 v223, v180, v176, s58
    v_mfma_f32_16x16x32_bf16 v[56:59], v[216:219], v[200:203], v[56:59]
    v_mfma_f32_16x16x32_bf16 v[60:63], v[216:219], v[204:207], v[60:63]
    v_perm_b32 v224, v157, v153, s57
    v_perm_b32 v225, v165, v161, s57
    v_perm_b32 v226, v173, v169, s57
    v_perm_b32 v227, v181, v177, s57
    v_mfma_f32_16x16x32_bf16 v[64:67], v[220:223], v[200:203], v[64:67]
    v_mfma_f32_16x16x32_bf16 v[68:71], v[220:223], v[204:207], v[68:71]
    v_perm_b32 v228, v157, v153, s58
    v_perm_b32 v229, v165, v161, s58
    v_perm_b32 v230, v173, v169, s58
    v_perm_b32 v231, v181, v177, s58
    v_mfma_f32_16x16x32_bf16 v[72:75], v[224:227], v[200:203], v[72:75]
    v_mfma_f32_16x16x32_bf16 v[76:79], v[224:227], v[204:207], v[76:79]
    v_perm_b32 v232, v158, v154, s57
    v_perm_b32 v233, v166, v162, s57
    v_perm_b32 v234, v174, v170, s57
    v_perm_b32 v235, v182, v178, s57
    v_mfma_f32_16x16x32_bf16 v[80:83], v[228:231], v[200:203], v[80:83]
    v_mfma_f32_16x16x32_bf16 v[84:87], v[228:231], v[204:207], v[84:87]
    v_perm_b32 v236, v158, v154, s58
    v_perm_b32 v237, v166, v162, s58
    v_perm_b32 v238, v174, v170, s58
    v_perm_b32 v239, v182, v178, s58
    v_mfma_f32_16x16x32_bf16 v[88:91], v[232:235], v[200:203], v[88:91]
    v_mfma_f32_16x16x32_bf16 v[92:95], v[232:235], v[204:207], v[92:95]
    v_perm_b32 v240, v159, v155, s57
    v_perm_b32 v241, v167, v163, s57
    v_perm_b32 v242, v175, v171, s57
    v_perm_b32 v243, v183, v179, s57
    v_mfma_f32_16x16x32_bf16 v[96:99], v[236:239], v[200:203], v[96:99]
    v_mfma_f32_16x16x32_bf16 v[100:103], v[236:239], v[204:207], v[100:103]
    v_perm_b32 v244, v159, v155, s58
    v_perm_b32 v245, v167, v163, s58
    v_perm_b32 v246, v175, v171, s58
    v_perm_b32 v247, v183, v179, s58
    v_mfma_f32_16x16x32_bf16 v[104:107], v[240:243], v[200:203], v[104:107]
    v_mfma_f32_16x16x32_bf16 v[108:111], v[240:243], v[204:207], v[108:111]
    s_bitcmp1_b32 s86, 0
    s_cbranch_scc1 L_nt4
    s_waitcnt vmcnt(1)
L_nt4:
    s_cmp_eq_u32 s50, 3
    s_cbranch_scc1 L_skip3
    buffer_load_dwordx4 v[120:123], v9, s[24:27], s52 offen offset:0 nt
    buffer_load_dwordx4 v[124:127], v252, s[24:27], s52 offen offset:0 nt
    buffer_load_dwordx4 v[128:131], v253, s[24:27], s52 offen offset:0 nt
    buffer_load_dwordx4 v[132:135], v254, s[24:27], s52 offen offset:0 nt
    buffer_load_dwordx4 v[136:139], v9, s[24:27], s53 offen offset:0 nt
    buffer_load_dwordx4 v[140:143], v252, s[24:27], s53 offen offset:0 nt
    buffer_load_dwordx4 v[144:147], v253, s[24:27], s53 offen offset:0 nt
    buffer_load_dwordx4 v[148:151], v254, s[24:27], s53 offen offset:0 nt
L_done3:
    v_mfma_f32_16x16x32_bf16 v[112:115], v[244:247], v[200:203], v[112:115]
    v_mfma_f32_16x16x32_bf16 v[116:119], v[244:247], v[204:207], v[116:119]
    s_add_u32 s50, s50, 1
    s_cmp_lt_u32 s50, 4
    s_cbranch_scc1 L_loop
    s_cmp_lt_u32 s48, 4
    s_cbranch_scc1 L_noxr
    v_mov_b32 v18, v12
    v_mov_b32 v19, v13
    s_nop 1
    v_permlane32_swap_b32 v12, v18
    v_permlane32_swap_b32 v13, v19
    s_nop 0
    v_add_f32 v12, v12, v18
    v_add_f32 v13, v13, v19
    v_mov_b32 v18, v12
    v_mov_b32 v19, v13
    s_nop 1
    v_permlane16_swap_b32 v12, v18
    v_permlane16_swap_b32 v13, v19
    s_nop 0
    v_add_f32 v12, v12, v18
    v_add_f32 v13, v13, v19
L_noxr:
    v_lshlrev_b32 v20, 4, v0
    v_add_u32 v21, s49, v20
    s_lshl_b32 s60, s48, 10
    s_add_u32 s60, s60, 131072
    v_add_u32 v22, s60, v20
    v_mov_b32 v216, v10
    v_mov_b32 v217, v12
    v_mov_b32 v218, v11
    v_mov_b32 v219, v13
    s_waitcnt vmcnt(0)
    ds_write_b128 v22, v[216:219]
    s_cmp_lt_u32 s48, 4
    s_cbranch_scc1 L_early
    v_lshrrev_b32 v1, 4, v0
    v_lshl_add_u32 v2, v1, 2, v0
    v_lshlrev_b32 v1, 8, v1
    v_add_u32 v1, s49, v1
    v_add_u32 v3, 0, v2
    v_and_b32 v3, 15, v3
    v_lshl_add_u32 v5, v3, 4, v1
    v_add_u32 v3, 1, v2
    v_and_b32 v3, 15, v3
    v_lshl_add_u32 v6, v3, 4, v1
    v_add_u32 v3, 2, v2
    v_and_b32 v3, 15, v3
    v_lshl_add_u32 v7, v3, 4, v1
    v_add_u32 v3, 3, v2
    v_and_b32 v3, 15, v3
    v_lshl_add_u32 v8, v3, 4, v1
    v_mov_b32 v120, v56
    v_mov_b32 v121, v64
    v_mov_b32 v122, v72
    v_mov_b32 v123, v80
    v_mov_b32 v124, v88
    v_mov_b32 v125, v96
    v_mov_b32 v126, v104
    v_mov_b32 v127, v112
    ds_write_b128 v5, v[120:123] offset:0
    ds_write_b128 v5, v[124:127] offset:1024
    v_mov_b32 v128, v57
    v_mov_b32 v129, v65
    v_mov_b32 v130, v73
    v_mov_b32 v131, v81
    v_mov_b32 v132, v89
    v_mov_b32 v133, v97
    v_mov_b32 v134, v105
    v_mov_b32 v135, v113
    ds_write_b128 v6, v[128:131] offset:2048
    ds_write_b128 v6, v[132:135] offset:3072
    v_mov_b32 v136, v58
    v_mov_b32 v137, v66
    v_mov_b32 v138, v74
    v_mov_b32 v139, v82
    v_mov_b32 v140, v90
    v_mov_b32 v141, v98
    v_mov_b32 v142, v106
    v_mov_b32 v143, v114
    ds_write_b128 v7, v[136:139] offset:4096
    ds_write_b128 v7, v[140:143] offset:5120
    v_mov_b32 v144, v59
    v_mov_b32 v145, v67
    v_mov_b32 v146, v75
    v_mov_b32 v147, v83
    v_mov_b32 v148, v91
    v_mov_b32 v149, v99
    v_mov_b32 v150, v107
    v_mov_b32 v151, v115
    ds_write_b128 v8, v[144:147] offset:6144
    ds_write_b128 v8, v[148:151] offset:7168
    v_mov_b32 v152, v60
    v_mov_b32 v153, v68
    v_mov_b32 v154, v76
    v_mov_b32 v155, v84
    v_mov_b32 v156, v92
    v_mov_b32 v157, v100
    v_mov_b32 v158, v108
    v_mov_b32 v159, v116
    ds_write_b128 v5, v[152:155] offset:8192
    ds_write_b128 v5, v[156:159] offset:9216
    v_mov_b32 v160, v61
    v_mov_b32 v161, v69
    v_mov_b32 v162, v77
    v_mov_b32 v163, v85
    v_mov_b32 v164, v93
    v_mov_b32 v165, v101
    v_mov_b32 v166, v109
    v_mov_b32 v167, v117
    ds_write_b128 v6, v[160:163] offset:10240
    ds_write_b128 v6, v[164:167] offset:11264
    v_mov_b32 v168, v62
    v_mov_b32 v169, v70
    v_mov_b32 v170, v78
    v_mov_b32 v171, v86
    v_mov_b32 v172, v94
    v_mov_b32 v173, v102
    v_mov_b32 v174, v110
    v_mov_b32 v175, v118
    ds_write_b128 v7, v[168:171] offset:12288
    ds_write_b128 v7, v[172:175] offset:13312
    v_mov_b32 v176, v63
    v_mov_b32 v177, v71
    v_mov_b32 v178, v79
    v_mov_b32 v179, v87
    v_mov_b32 v180, v95
    v_mov_b32 v181, v103
    v_mov_b32 v182, v111
    v_mov_b32 v183, v119
    ds_write_b128 v8, v[176:179] offset:14336
    ds_write_b128 v8, v[180:183] offset:15360
L_rd:
    s_lshr_b32 s60, s48, 2
    s_and_b32 s62, s48, 3
    s_lshl_b32 s62, s62, 2
    v_lshrrev_b32 v1, 4, v0
    v_add_u32 v1, s62, v1
    s_lshl_b32 s61, s60, 3
    s_add_u32 s61, s61, 131072
    v_lshl_add_u32 v22, v1, 4, s61
    v_add_u32 v1, v1, v0
    v_and_b32 v1, 15, v1
    v_and_b32 v2, 3, v0
    v_bfe_u32 v3, v0, 2, 2
    v_lshlrev_b32 v1, 4, v1
    v_lshl_add_u32 v1, v3, 8, v1
    v_lshl_add_u32 v1, v2, 11, v1
    s_lshl_b32 s61, s60, 13
    s_add_u32 s61, s61, 0x10000
    v_add_u32 v23, s61, v1
    v_mov_b32 v1, v20
    s_lshl_b32 s60, s48, 10
    s_lshl_b32 s61, s2, 13
    s_add_u32 s60, s60, s61
    s_waitcnt lgkmcnt(0)
    s_barrier
L_final:
    ds_read_b64 v[24:25], v22 offset:4096
    ds_read_b64 v[26:27], v22 offset:5120
    ds_read_b64 v[28:29], v22 offset:6144
    ds_read_b64 v[30:31], v22 offset:7168
    ds_read_b128 v[56:59], v23 offset:0
    ds_read_b128 v[60:63], v23 offset:1024
    ds_read_b128 v[64:67], v23 offset:16384
    ds_read_b128 v[68:71], v23 offset:17408
    ds_read_b128 v[72:75], v23 offset:32768
    ds_read_b128 v[76:79], v23 offset:33792
    ds_read_b128 v[80:83], v23 offset:49152
    ds_read_b128 v[84:87], v23 offset:50176
    s_waitcnt lgkmcnt(8)
    v_max3_f32 v2, v24, v26, v28
    v_max_f32 v2, v2, v30
    v_sub_f32 v24, v24, v2
    v_sub_f32 v26, v26, v2
    v_sub_f32 v28, v28, v2
    v_sub_f32 v30, v30, v2
    v_mul_f32 v24, s56, v24
    v_mul_f32 v26, s56, v26
    v_mul_f32 v28, s56, v28
    v_mul_f32 v30, s56, v30
    v_exp_f32 v24, v24
    v_exp_f32 v26, v26
    v_exp_f32 v28, v28
    v_exp_f32 v30, v30
    s_nop 0
    v_mul_f32 v3, v24, v25
    v_fmac_f32 v3, v26, v27
    v_fmac_f32 v3, v28, v29
    v_fmac_f32 v3, v30, v31
    v_rcp_f32 v3, v3
    s_waitcnt lgkmcnt(6)
    v_mul_f32 v120, v24, v56
    v_mul_f32 v121, v24, v57
    v_mul_f32 v122, v24, v58
    v_mul_f32 v123, v24, v59
    v_mul_f32 v124, v24, v60
    v_mul_f32 v125, v24, v61
    v_mul_f32 v126, v24, v62
    v_mul_f32 v127, v24, v63
    s_waitcnt lgkmcnt(4)
    v_fmac_f32 v120, v26, v64
    v_fmac_f32 v121, v26, v65
    v_fmac_f32 v122, v26, v66
    v_fmac_f32 v123, v26, v67
    v_fmac_f32 v124, v26, v68
    v_fmac_f32 v125, v26, v69
    v_fmac_f32 v126, v26, v70
    v_fmac_f32 v127, v26, v71
    s_waitcnt lgkmcnt(2)
    v_fmac_f32 v120, v28, v72
    v_fmac_f32 v121, v28, v73
    v_fmac_f32 v122, v28, v74
    v_fmac_f32 v123, v28, v75
    v_fmac_f32 v124, v28, v76
    v_fmac_f32 v125, v28, v77
    v_fmac_f32 v126, v28, v78
    v_fmac_f32 v127, v28, v79
    s_waitcnt lgkmcnt(0)
    v_fmac_f32 v120, v30, v80
    v_fmac_f32 v121, v30, v81
    v_fmac_f32 v122, v30, v82
    v_fmac_f32 v123, v30, v83
    v_fmac_f32 v124, v30, v84
    v_fmac_f32 v125, v30, v85
    v_fmac_f32 v126, v30, v86
    v_fmac_f32 v127, v30, v87
    v_mul_f32 v120, v120, v3
    v_mul_f32 v121, v121, v3
    v_mul_f32 v122, v122, v3
    v_mul_f32 v123, v123, v3
    v_mul_f32 v124, v124, v3
    v_mul_f32 v125, v125, v3
    v_mul_f32 v126, v126, v3
    v_mul_f32 v127, v127, v3
    v_cvt_pk_bf16_f32 v40, v120, v121
    v_cvt_pk_bf16_f32 v41, v122, v123
    v_cvt_pk_bf16_f32 v42, v124, v125
    v_cvt_pk_bf16_f32 v43, v126, v127
    buffer_store_dwordx4 v[40:43], v1, s[44:47], s60 offen offset:0 nt
L_end:
    s_endpgm
L_skip1:
    s_nop 7
    s_nop 7
    s_branch L_done1
L_w2:
    s_waitcnt vmcnt(8)
    s_branch L_wd2
L_skip2:
    s_nop 7
    s_nop 7
    s_branch L_done2
L_w3:
    s_waitcnt vmcnt(0)
    s_branch L_wd3
L_skip3:
    s_nop 7
    s_nop 7
    s_branch L_done3
L_early:
    s_nop 7
    s_nop 7
    ds_write_b128 v21, v[56:59] offset:0
    ds_write_b128 v21, v[60:63] offset:1024
    ds_write_b128 v21, v[64:67] offset:2048
    ds_write_b128 v21, v[68:71] offset:3072
    ds_write_b128 v21, v[72:75] offset:4096
    ds_write_b128 v21, v[76:79] offset:5120
    ds_write_b128 v21, v[80:83] offset:6144
    ds_write_b128 v21, v[84:87] offset:7168
    ds_write_b128 v21, v[88:91] offset:8192
    ds_write_b128 v21, v[92:95] offset:9216
    ds_write_b128 v21, v[96:99] offset:10240
    ds_write_b128 v21, v[100:103] offset:11264
    ds_write_b128 v21, v[104:107] offset:12288
    ds_write_b128 v21, v[108:111] offset:13312
    ds_write_b128 v21, v[112:115] offset:14336
    ds_write_b128 v21, v[116:119] offset:15360
    s_waitcnt lgkmcnt(0)
    s_barrier
    s_branch L_rd
L_merge:
    s_barrier
    v_lshlrev_b32 v20, 4, v0
    s_sub_u32 s60, s49, 0x10000
    v_add_u32 v21, s60, v20
    s_lshl_b32 s60, s48, 10
    s_add_u32 s60, s60, 126976
    v_add_u32 v22, s60, v20
    ds_read_b128 v[248:251], v22
    ds_read_b128 v[184:187], v21 offset:0
    ds_read_b128 v[188:191], v21 offset:1024
    ds_read_b128 v[192:195], v21 offset:2048
    ds_read_b128 v[196:199], v21 offset:3072
    ds_read_b128 v[200:203], v21 offset:4096
    ds_read_b128 v[204:207], v21 offset:5120
    ds_read_b128 v[208:211], v21 offset:6144
    ds_read_b128 v[212:215], v21 offset:7168
    ds_read_b128 v[216:219], v21 offset:8192
    ds_read_b128 v[220:223], v21 offset:9216
    ds_read_b128 v[224:227], v21 offset:10240
    ds_read_b128 v[228:231], v21 offset:11264
    ds_read_b128 v[232:235], v21 offset:12288
    ds_read_b128 v[236:239], v21 offset:13312
    ds_read_b128 v[240:243], v21 offset:14336
    ds_read_b128 v[244:247], v21 offset:15360
    s_waitcnt lgkmcnt(15)
    v_max_f32 v18, v10, v248
    v_max_f32 v19, v11, v250
    v_sub_f32 v14, v10, v18
    v_sub_f32 v16, v248, v18
    v_mul_f32 v14, s56, v14
    v_mul_f32 v16, s56, v16
    v_mov_b32 v10, v18
    v_sub_f32 v15, v11, v19
    v_sub_f32 v17, v250, v19
    v_mul_f32 v15, s56, v15
    v_mul_f32 v17, s56, v17
    v_mov_b32 v11, v19
    v_exp_f32 v14, v14
    v_exp_f32 v16, v16
    v_exp_f32 v15, v15
    v_exp_f32 v17, v17
    s_nop 1
    v_mul_f32 v12, v12, v14
    v_fmac_f32 v12, v249, v16
    v_mul_f32 v13, v13, v15
    v_fmac_f32 v13, v251, v17
    v_pk_mul_f32 v[56:57], v[56:57], v[14:15] op_sel:[0,0] op_sel_hi:[1,0]
    v_pk_mul_f32 v[58:59], v[58:59], v[14:15] op_sel:[0,0] op_sel_hi:[1,0]
    v_pk_mul_f32 v[60:61], v[60:61], v[14:15] op_sel:[0,1] op_sel_hi:[1,1]
    v_pk_mul_f32 v[62:63], v[62:63], v[14:15] op_sel:[0,1] op_sel_hi:[1,1]
    v_pk_mul_f32 v[64:65], v[64:65], v[14:15] op_sel:[0,0] op_sel_hi:[1,0]
    v_pk_mul_f32 v[66:67], v[66:67], v[14:15] op_sel:[0,0] op_sel_hi:[1,0]
    v_pk_mul_f32 v[68:69], v[68:69], v[14:15] op_sel:[0,1] op_sel_hi:[1,1]
    v_pk_mul_f32 v[70:71], v[70:71], v[14:15] op_sel:[0,1] op_sel_hi:[1,1]
    v_pk_mul_f32 v[72:73], v[72:73], v[14:15] op_sel:[0,0] op_sel_hi:[1,0]
    v_pk_mul_f32 v[74:75], v[74:75], v[14:15] op_sel:[0,0] op_sel_hi:[1,0]
    v_pk_mul_f32 v[76:77], v[76:77], v[14:15] op_sel:[0,1] op_sel_hi:[1,1]
    v_pk_mul_f32 v[78:79], v[78:79], v[14:15] op_sel:[0,1] op_sel_hi:[1,1]
    v_pk_mul_f32 v[80:81], v[80:81], v[14:15] op_sel:[0,0] op_sel_hi:[1,0]
    v_pk_mul_f32 v[82:83], v[82:83], v[14:15] op_sel:[0,0] op_sel_hi:[1,0]
    v_pk_mul_f32 v[84:85], v[84:85], v[14:15] op_sel:[0,1] op_sel_hi:[1,1]
    v_pk_mul_f32 v[86:87], v[86:87], v[14:15] op_sel:[0,1] op_sel_hi:[1,1]
    v_pk_mul_f32 v[88:89], v[88:89], v[14:15] op_sel:[0,0] op_sel_hi:[1,0]
    v_pk_mul_f32 v[90:91], v[90:91], v[14:15] op_sel:[0,0] op_sel_hi:[1,0]
    v_pk_mul_f32 v[92:93], v[92:93], v[14:15] op_sel:[0,1] op_sel_hi:[1,1]
    v_pk_mul_f32 v[94:95], v[94:95], v[14:15] op_sel:[0,1] op_sel_hi:[1,1]
    v_pk_mul_f32 v[96:97], v[96:97], v[14:15] op_sel:[0,0] op_sel_hi:[1,0]
    v_pk_mul_f32 v[98:99], v[98:99], v[14:15] op_sel:[0,0] op_sel_hi:[1,0]
    v_pk_mul_f32 v[100:101], v[100:101], v[14:15] op_sel:[0,1] op_sel_hi:[1,1]
    v_pk_mul_f32 v[102:103], v[102:103], v[14:15] op_sel:[0,1] op_sel_hi:[1,1]
    v_pk_mul_f32 v[104:105], v[104:105], v[14:15] op_sel:[0,0] op_sel_hi:[1,0]
    v_pk_mul_f32 v[106:107], v[106:107], v[14:15] op_sel:[0,0] op_sel_hi:[1,0]
    v_pk_mul_f32 v[108:109], v[108:109], v[14:15] op_sel:[0,1] op_sel_hi:[1,1]
    v_pk_mul_f32 v[110:111], v[110:111], v[14:15] op_sel:[0,1] op_sel_hi:[1,1]
    v_pk_mul_f32 v[112:113], v[112:113], v[14:15] op_sel:[0,0] op_sel_hi:[1,0]
    v_pk_mul_f32 v[114:115], v[114:115], v[14:15] op_sel:[0,0] op_sel_hi:[1,0]
    v_pk_mul_f32 v[116:117], v[116:117], v[14:15] op_sel:[0,1] op_sel_hi:[1,1]
    v_pk_mul_f32 v[118:119], v[118:119], v[14:15] op_sel:[0,1] op_sel_hi:[1,1]
    s_waitcnt lgkmcnt(15)
    v_pk_fma_f32 v[56:57], v[184:185], v[16:17], v[56:57] op_sel:[0,0,0] op_sel_hi:[1,0,1]
    v_pk_fma_f32 v[58:59], v[186:187], v[16:17], v[58:59] op_sel:[0,0,0] op_sel_hi:[1,0,1]
    s_waitcnt lgkmcnt(14)
    v_pk_fma_f32 v[60:61], v[188:189], v[16:17], v[60:61] op_sel:[0,1,0] op_sel_hi:[1,1,1]
    v_pk_fma_f32 v[62:63], v[190:191], v[16:17], v[62:63] op_sel:[0,1,0] op_sel_hi:[1,1,1]
    s_waitcnt lgkmcnt(13)
    v_pk_fma_f32 v[64:65], v[192:193], v[16:17], v[64:65] op_sel:[0,0,0] op_sel_hi:[1,0,1]
    v_pk_fma_f32 v[66:67], v[194:195], v[16:17], v[66:67] op_sel:[0,0,0] op_sel_hi:[1,0,1]
    s_waitcnt lgkmcnt(12)
    v_pk_fma_f32 v[68:69], v[196:197], v[16:17], v[68:69] op_sel:[0,1,0] op_sel_hi:[1,1,1]
    v_pk_fma_f32 v[70:71], v[198:199], v[16:17], v[70:71] op_sel:[0,1,0] op_sel_hi:[1,1,1]
    s_waitcnt lgkmcnt(11)
    v_pk_fma_f32 v[72:73], v[200:201], v[16:17], v[72:73] op_sel:[0,0,0] op_sel_hi:[1,0,1]
    v_pk_fma_f32 v[74:75], v[202:203], v[16:17], v[74:75] op_sel:[0,0,0] op_sel_hi:[1,0,1]
    s_waitcnt lgkmcnt(10)
    v_pk_fma_f32 v[76:77], v[204:205], v[16:17], v[76:77] op_sel:[0,1,0] op_sel_hi:[1,1,1]
    v_pk_fma_f32 v[78:79], v[206:207], v[16:17], v[78:79] op_sel:[0,1,0] op_sel_hi:[1,1,1]
    s_waitcnt lgkmcnt(9)
    v_pk_fma_f32 v[80:81], v[208:209], v[16:17], v[80:81] op_sel:[0,0,0] op_sel_hi:[1,0,1]
    v_pk_fma_f32 v[82:83], v[210:211], v[16:17], v[82:83] op_sel:[0,0,0] op_sel_hi:[1,0,1]
    s_waitcnt lgkmcnt(8)
    v_pk_fma_f32 v[84:85], v[212:213], v[16:17], v[84:85] op_sel:[0,1,0] op_sel_hi:[1,1,1]
    v_pk_fma_f32 v[86:87], v[214:215], v[16:17], v[86:87] op_sel:[0,1,0] op_sel_hi:[1,1,1]
    s_waitcnt lgkmcnt(7)
    v_pk_fma_f32 v[88:89], v[216:217], v[16:17], v[88:89] op_sel:[0,0,0] op_sel_hi:[1,0,1]
    v_pk_fma_f32 v[90:91], v[218:219], v[16:17], v[90:91] op_sel:[0,0,0] op_sel_hi:[1,0,1]
    s_waitcnt lgkmcnt(6)
    v_pk_fma_f32 v[92:93], v[220:221], v[16:17], v[92:93] op_sel:[0,1,0] op_sel_hi:[1,1,1]
    v_pk_fma_f32 v[94:95], v[222:223], v[16:17], v[94:95] op_sel:[0,1,0] op_sel_hi:[1,1,1]
    s_waitcnt lgkmcnt(5)
    v_pk_fma_f32 v[96:97], v[224:225], v[16:17], v[96:97] op_sel:[0,0,0] op_sel_hi:[1,0,1]
    v_pk_fma_f32 v[98:99], v[226:227], v[16:17], v[98:99] op_sel:[0,0,0] op_sel_hi:[1,0,1]
    s_waitcnt lgkmcnt(4)
    v_pk_fma_f32 v[100:101], v[228:229], v[16:17], v[100:101] op_sel:[0,1,0] op_sel_hi:[1,1,1]
    v_pk_fma_f32 v[102:103], v[230:231], v[16:17], v[102:103] op_sel:[0,1,0] op_sel_hi:[1,1,1]
    s_waitcnt lgkmcnt(3)
    v_pk_fma_f32 v[104:105], v[232:233], v[16:17], v[104:105] op_sel:[0,0,0] op_sel_hi:[1,0,1]
    v_pk_fma_f32 v[106:107], v[234:235], v[16:17], v[106:107] op_sel:[0,0,0] op_sel_hi:[1,0,1]
    s_waitcnt lgkmcnt(2)
    v_pk_fma_f32 v[108:109], v[236:237], v[16:17], v[108:109] op_sel:[0,1,0] op_sel_hi:[1,1,1]
    v_pk_fma_f32 v[110:111], v[238:239], v[16:17], v[110:111] op_sel:[0,1,0] op_sel_hi:[1,1,1]
    s_waitcnt lgkmcnt(1)
    v_pk_fma_f32 v[112:113], v[240:241], v[16:17], v[112:113] op_sel:[0,0,0] op_sel_hi:[1,0,1]
    v_pk_fma_f32 v[114:115], v[242:243], v[16:17], v[114:115] op_sel:[0,0,0] op_sel_hi:[1,0,1]
    s_waitcnt lgkmcnt(0)
    v_pk_fma_f32 v[116:117], v[244:245], v[16:17], v[116:117] op_sel:[0,1,0] op_sel_hi:[1,1,1]
    v_pk_fma_f32 v[118:119], v[246:247], v[16:17], v[118:119] op_sel:[0,1,0] op_sel_hi:[1,1,1]
    s_branch L_loop4
L_treeld:
    s_lshl_b32 s60, s2, 11
    s_lshl_b32 s61, s48, 9
    s_add_u32 s60, s60, s61
    v_and_b32 v21, 31, v0
    v_lshlrev_b32 v21, 4, v21
    s_lshl_b32 s61, s48, 11
    s_add_u32 m0, s61, 139264
    s_nop 0
    buffer_load_dwordx4 v21, s[32:35], s60 offen lds
    s_add_u32 m0, s61, 140288
    s_nop 0
    buffer_load_dwordx4 v21, s[36:39], s60 offen lds
    v_mov_b32 v22, s63
    v_cmp_gt_u32 vcc, 16, v0
    v_and_b32 v21, 7, v0
    v_lshlrev_b32 v21, 4, v21
    v_cndmask_b32 v21, v22, v21, vcc
    s_lshr_b32 s60, s2, 3
    s_lshl_b32 s60, s60, 7
    s_lshl_b32 s61, s48, 2
    s_add_u32 s60, s60, s61
    buffer_load_dword v248, v21, s[40:43], s60 offen
    s_branch L_loop3
L_tree:
    s_lshl_b32 s61, s48, 11
    s_add_u32 s61, s61, 139264
    v_and_b32 v18, 1, v0
    v_lshrrev_b32 v19, 4, v0
    v_lshlrev_b32 v20, 4, v19
    v_lshl_add_u32 v20, v18, 8, v20
    v_and_b32 v18, 15, v0
    v_lshlrev_b32 v21, 4, v18
    v_add_u32 v20, s61, v20
    v_add_u32 v21, s61, v21
    v_add_u32 v21, 0x400, v21
    v_mov_b32 v249, 0
    ds_read_b128 v[216:219], v20 offset:0
    ds_read_b128 v[220:223], v20 offset:64
    ds_read_b128 v[224:227], v20 offset:128
    ds_read_b128 v[228:231], v20 offset:192
    ds_read_b128 v[232:235], v21 offset:0
    ds_read_b128 v[236:239], v21 offset:256
    ds_read_b128 v[240:243], v21 offset:512
    ds_read_b128 v[244:247], v21 offset:768
    v_lshlrev_b32 v200, 16, v248
    v_and_b32 v201, 0xffff0000, v248
    v_lshlrev_b32 v202, 16, v249
    v_and_b32 v203, 0xffff0000, v249
    v_mov_b32 v20, s59
    v_fma_f32 v200, v200, v20, -v20
    v_fma_f32 v201, v201, v20, -v20
    v_fma_f32 v202, v202, v20, -v20
    v_fma_f32 v203, v203, v20, -v20
    s_waitcnt lgkmcnt(0)
    v_mfma_f32_16x16x32_bf16 v[184:187], v[216:219], v[24:27], 0
    v_mfma_f32_16x16x32_bf16 v[188:191], v[216:219], v[40:43], 0
    v_mfma_f32_16x16x32_bf16 v[184:187], v[220:223], v[28:31], v[184:187]
    v_mfma_f32_16x16x32_bf16 v[188:191], v[220:223], v[44:47], v[188:191]
    v_mfma_f32_16x16x32_bf16 v[184:187], v[224:227], v[32:35], v[184:187]
    v_mfma_f32_16x16x32_bf16 v[188:191], v[224:227], v[48:51], v[188:191]
    v_mfma_f32_16x16x32_bf16 v[184:187], v[228:231], v[36:39], v[184:187]
    v_mfma_f32_16x16x32_bf16 v[188:191], v[228:231], v[52:55], v[188:191]
    s_nop 7
    s_nop 1
    v_add_f32 v184, v184, v200
    v_add_f32 v185, v185, v201
    v_add_f32 v186, v186, v202
    v_add_f32 v187, v187, v203
    v_add_f32 v188, v188, v200
    v_add_f32 v189, v189, v201
    v_add_f32 v190, v190, v202
    v_add_f32 v191, v191, v203
    v_max3_f32 v18, v184, v185, v186
    v_max3_f32 v18, v18, v187, v10
    v_max3_f32 v19, v188, v189, v190
    v_max3_f32 v19, v19, v191, v11
    v_mov_b32 v20, v18
    v_mov_b32 v21, v19
    s_nop 1
    v_permlane32_swap_b32 v18, v20
    v_permlane32_swap_b32 v19, v21
    s_nop 0
    v_max_f32 v18, v18, v20
    v_max_f32 v19, v19, v21
    v_mov_b32 v20, v18
    v_mov_b32 v21, v19
    s_nop 1
    v_permlane16_swap_b32 v18, v20
    v_permlane16_swap_b32 v19, v21
    s_nop 0
    v_max_f32 v18, v18, v20
    v_max_f32 v19, v19, v21
    v_sub_f32 v14, v10, v18
    v_mul_f32 v16, s56, v18
    v_mul_f32 v14, s56, v14
    v_mov_b32 v10, v18
    v_sub_f32 v15, v11, v19
    v_mul_f32 v17, s56, v19
    v_mul_f32 v15, s56, v15
    v_mov_b32 v11, v19
    v_exp_f32 v14, v14
    v_exp_f32 v15, v15
    v_fma_f32 v184, v184, s56, -v16
    v_fma_f32 v185, v185, s56, -v16
    v_fma_f32 v186, v186, s56, -v16
    v_fma_f32 v187, v187, s56, -v16
    v_fma_f32 v188, v188, s56, -v17
    v_fma_f32 v189, v189, s56, -v17
    v_fma_f32 v190, v190, s56, -v17
    v_fma_f32 v191, v191, s56, -v17
    v_exp_f32 v184, v184
    v_exp_f32 v185, v185
    v_exp_f32 v186, v186
    v_exp_f32 v187, v187
    v_exp_f32 v188, v188
    v_exp_f32 v189, v189
    v_exp_f32 v190, v190
    v_exp_f32 v191, v191
    v_pk_mul_f32 v[56:57], v[56:57], v[14:15] op_sel:[0,0] op_sel_hi:[1,0]
    v_pk_mul_f32 v[58:59], v[58:59], v[14:15] op_sel:[0,0] op_sel_hi:[1,0]
    v_pk_mul_f32 v[60:61], v[60:61], v[14:15] op_sel:[0,1] op_sel_hi:[1,1]
    v_pk_mul_f32 v[62:63], v[62:63], v[14:15] op_sel:[0,1] op_sel_hi:[1,1]
    v_pk_mul_f32 v[64:65], v[64:65], v[14:15] op_sel:[0,0] op_sel_hi:[1,0]
    v_pk_mul_f32 v[66:67], v[66:67], v[14:15] op_sel:[0,0] op_sel_hi:[1,0]
    v_pk_mul_f32 v[68:69], v[68:69], v[14:15] op_sel:[0,1] op_sel_hi:[1,1]
    v_pk_mul_f32 v[70:71], v[70:71], v[14:15] op_sel:[0,1] op_sel_hi:[1,1]
    v_pk_mul_f32 v[72:73], v[72:73], v[14:15] op_sel:[0,0] op_sel_hi:[1,0]
    v_pk_mul_f32 v[74:75], v[74:75], v[14:15] op_sel:[0,0] op_sel_hi:[1,0]
    v_pk_mul_f32 v[76:77], v[76:77], v[14:15] op_sel:[0,1] op_sel_hi:[1,1]
    v_pk_mul_f32 v[78:79], v[78:79], v[14:15] op_sel:[0,1] op_sel_hi:[1,1]
    v_pk_mul_f32 v[80:81], v[80:81], v[14:15] op_sel:[0,0] op_sel_hi:[1,0]
    v_pk_mul_f32 v[82:83], v[82:83], v[14:15] op_sel:[0,0] op_sel_hi:[1,0]
    v_pk_mul_f32 v[84:85], v[84:85], v[14:15] op_sel:[0,1] op_sel_hi:[1,1]
    v_pk_mul_f32 v[86:87], v[86:87], v[14:15] op_sel:[0,1] op_sel_hi:[1,1]
    v_pk_mul_f32 v[88:89], v[88:89], v[14:15] op_sel:[0,0] op_sel_hi:[1,0]
    v_pk_mul_f32 v[90:91], v[90:91], v[14:15] op_sel:[0,0] op_sel_hi:[1,0]
    v_pk_mul_f32 v[92:93], v[92:93], v[14:15] op_sel:[0,1] op_sel_hi:[1,1]
    v_pk_mul_f32 v[94:95], v[94:95], v[14:15] op_sel:[0,1] op_sel_hi:[1,1]
    v_pk_mul_f32 v[96:97], v[96:97], v[14:15] op_sel:[0,0] op_sel_hi:[1,0]
    v_pk_mul_f32 v[98:99], v[98:99], v[14:15] op_sel:[0,0] op_sel_hi:[1,0]
    v_pk_mul_f32 v[100:101], v[100:101], v[14:15] op_sel:[0,1] op_sel_hi:[1,1]
    v_pk_mul_f32 v[102:103], v[102:103], v[14:15] op_sel:[0,1] op_sel_hi:[1,1]
    v_pk_mul_f32 v[104:105], v[104:105], v[14:15] op_sel:[0,0] op_sel_hi:[1,0]
    v_pk_mul_f32 v[106:107], v[106:107], v[14:15] op_sel:[0,0] op_sel_hi:[1,0]
    v_pk_mul_f32 v[108:109], v[108:109], v[14:15] op_sel:[0,1] op_sel_hi:[1,1]
    v_pk_mul_f32 v[110:111], v[110:111], v[14:15] op_sel:[0,1] op_sel_hi:[1,1]
    v_pk_mul_f32 v[112:113], v[112:113], v[14:15] op_sel:[0,0] op_sel_hi:[1,0]
    v_pk_mul_f32 v[114:115], v[114:115], v[14:15] op_sel:[0,0] op_sel_hi:[1,0]
    v_pk_mul_f32 v[116:117], v[116:117], v[14:15] op_sel:[0,1] op_sel_hi:[1,1]
    v_pk_mul_f32 v[118:119], v[118:119], v[14:15] op_sel:[0,1] op_sel_hi:[1,1]
    v_add_f32 v20, v184, v185
    v_add_f32 v18, v186, v187
    v_add_f32 v18, v20, v18
    v_fma_f32 v12, v12, v14, v18
    v_cvt_pk_bf16_f32 v184, v184, v185
    v_cvt_pk_bf16_f32 v185, v186, v187
    v_add_f32 v21, v188, v189
    v_add_f32 v19, v190, v191
    v_add_f32 v19, v21, v19
    v_fma_f32 v13, v13, v15, v19
    v_cvt_pk_bf16_f32 v188, v188, v189
    v_cvt_pk_bf16_f32 v189, v190, v191
    v_perm_b32 v200, v236, v232, s57
    v_perm_b32 v201, v244, v240, s57
    v_perm_b32 v202, v236, v232, s58
    v_perm_b32 v203, v244, v240, s58
    v_perm_b32 v204, v237, v233, s57
    v_perm_b32 v205, v245, v241, s57
    v_perm_b32 v206, v237, v233, s58
    v_perm_b32 v207, v245, v241, s58
    v_perm_b32 v208, v238, v234, s57
    v_perm_b32 v209, v246, v242, s57
    v_perm_b32 v210, v238, v234, s58
    v_perm_b32 v211, v246, v242, s58
    v_perm_b32 v212, v239, v235, s57
    v_perm_b32 v213, v247, v243, s57
    v_perm_b32 v214, v239, v235, s58
    v_perm_b32 v215, v247, v243, s58
    s_nop 1
    v_mfma_f32_16x16x16_bf16 v[56:59], v[200:201], v[184:185], v[56:59]
    v_mfma_f32_16x16x16_bf16 v[60:63], v[200:201], v[188:189], v[60:63]
    v_mfma_f32_16x16x16_bf16 v[64:67], v[202:203], v[184:185], v[64:67]
    v_mfma_f32_16x16x16_bf16 v[68:71], v[202:203], v[188:189], v[68:71]
    v_mfma_f32_16x16x16_bf16 v[72:75], v[204:205], v[184:185], v[72:75]
    v_mfma_f32_16x16x16_bf16 v[76:79], v[204:205], v[188:189], v[76:79]
    v_mfma_f32_16x16x16_bf16 v[80:83], v[206:207], v[184:185], v[80:83]
    v_mfma_f32_16x16x16_bf16 v[84:87], v[206:207], v[188:189], v[84:87]
    v_mfma_f32_16x16x16_bf16 v[88:91], v[208:209], v[184:185], v[88:91]
    v_mfma_f32_16x16x16_bf16 v[92:95], v[208:209], v[188:189], v[92:95]
    v_mfma_f32_16x16x16_bf16 v[96:99], v[210:211], v[184:185], v[96:99]
    v_mfma_f32_16x16x16_bf16 v[100:103], v[210:211], v[188:189], v[100:103]
    v_mfma_f32_16x16x16_bf16 v[104:107], v[212:213], v[184:185], v[104:107]
    v_mfma_f32_16x16x16_bf16 v[108:111], v[212:213], v[188:189], v[108:111]
    v_mfma_f32_16x16x16_bf16 v[112:115], v[214:215], v[184:185], v[112:115]
    v_mfma_f32_16x16x16_bf16 v[116:119], v[214:215], v[188:189], v[116:119]
    s_nop 7
    s_branch L_loop2
.section .rodata,"a"
.p2align 6
.amdhsa_kernel standalone__tree_speculative_verify_tree_attention_over_candidate_token_tree__sampling_kernel
  .amdhsa_next_free_vgpr 256
  .amdhsa_next_free_sgpr 96
  .amdhsa_accum_offset 256
  .amdhsa_group_segment_fixed_size 0
  .amdhsa_kernarg_size 72
  .amdhsa_user_sgpr_count 2
  .amdhsa_user_sgpr_kernarg_segment_ptr 1
  .amdhsa_system_sgpr_workgroup_id_x 1
.end_amdhsa_kernel
```
